```python
import torch

def _softmax(x, axis=-1):
    return torch.softmax(x, dim=axis)
def _gelu(x):
    return torch.nn.functional.gelu(x, approximate="tanh")
def _silu(x):
    return torch.nn.functional.silu(x)
def _sigmoid(x):
    return torch.sigmoid(x)
def _layernorm(x, axis=-1, eps=1e-5):
    m = x.mean(dim=axis, keepdim=True)
    v = x.var(dim=axis, keepdim=True, unbiased=False)
    return (x - m) / torch.sqrt(v + eps)
def _scatter_add(tgt, idx, src, axis=0):
    return tgt.clone().index_add_(axis, idx, src)
def _segment_sum(src, seg, n):
    out = torch.zeros((n,) + src.shape[1:], dtype=src.dtype)
    return out.index_add_(0, seg, src)
def _pad(x, pw):
    flat = tuple(v for pair in reversed(pw) for v in pair)
    return torch.nn.functional.pad(x, flat)

kernel_name = 'recurrent_scan__sliding_block_cached__dense_activation_squared_relu__decode'

def setup_inputs():

    _w = (lambda a: (lambda t: t.to(torch.bfloat16) if t.is_floating_point() else t)(torch.as_tensor(a)))
    def _A_setup():
        B, Sq, D = 2, 1, 512
        Hq, Hkv, Sk, Dh = 32, 8, 32768, 128
        assert Hq % Hkv == 0, (Hq, Hkv)
        return {
            "x": _w((lambda *s: torch.randn(*s, dtype=torch.bfloat16) * 0.05)(B, Sq, D)),
            "k_cache": _w((lambda *s: torch.randn(*s, dtype=torch.bfloat16) * 1.6)(B, Hkv, Sk, Dh)),
            "v_cache": _w((lambda *s: torch.randn(*s, dtype=torch.bfloat16) * 0.2)(B, Hkv, Sk, Dh)),
            "wq": _w((lambda *s: torch.randn(*s, dtype=torch.bfloat16) * 1.6)(D, Hq * Dh) * (D ** -0.5)),
            "wo": _w((lambda *s: torch.randn(*s, dtype=torch.bfloat16) * 0.2)(Hq * Dh, D) * ((Hq * Dh) ** -0.5)),
        }
    _A_in = _A_setup()

    def _B_setup():
        B, S, D, F = 2, 1, 512, 1792
        return {
            "x": _w((lambda *s: torch.randn(*s, dtype=torch.bfloat16) * 0.05)(B, S, D)),
            "w1": _w((lambda *s: torch.randn(*s, dtype=torch.bfloat16) * 0.1)(D, F)),
            "b1": _w((lambda *s: torch.randn(*s, dtype=torch.bfloat16) * 0.8)(F)),
            "w2": _w((lambda *s: torch.randn(*s, dtype=torch.bfloat16) * 0.1)(F, D)),
            "b2": _w((lambda *s: torch.randn(*s, dtype=torch.bfloat16) * 12.8)(D)),
        }
    _B_in = _B_setup()

    return {
        "A_x": _A_in["x"],
        "A_k_cache": _A_in["k_cache"],
        "A_v_cache": _A_in["v_cache"],
        "A_wq": _A_in["wq"],
        "A_wo": _A_in["wo"],
        "B_x": _B_in["x"],
        "B_w1": _B_in["w1"],
        "B_b1": _B_in["b1"],
        "B_w2": _B_in["w2"],
        "B_b2": _B_in["b2"],
    }

def reference(A_x, A_k_cache, A_v_cache, A_wq, A_wo, B_x, B_w1, B_b1, B_w2, B_b2):
    def _A_ref(x, k_cache, v_cache, wq, wo):
        B, Sq, D = x.shape
        Hq, Dh = 32, 128
        Hkv, Sk = k_cache.shape[1], k_cache.shape[2]
        W = min(4096, max(256, Sk // 4))
        rep = Hq // Hkv
        q = (lambda x, *d: x.permute(*d))((x @ wq).reshape(B, Sq, Hq, Dh), 0, 2, 1, 3)
        k = (lambda x, n, axis: torch.repeat_interleave(x, n, dim=axis))(k_cache[:, :, Sk - W:, :], rep, axis=1)
        v = (lambda x, n, axis: torch.repeat_interleave(x, n, dim=axis))(v_cache[:, :, Sk - W:, :], rep, axis=1)
        scores = torch.einsum("bhqd,bhkd->bhqk", q, k) * (Dh ** -0.5)
        p = _softmax(scores, axis=-1)
        o = torch.einsum("bhqk,bhkd->bhqd", p, v)
        return (lambda x, *d: x.permute(*d))(o, 0, 2, 1, 3).reshape(B, Sq, Hq * Dh) @ wo

    def _B_ref(x, w1, b1, w2, b2):
        h = torch.einsum("bsd,df->bsf", x, w1) + b1
        zero = torch.zeros_like(h)
        r = torch.where(h > zero, h, zero)
        h = r * r
        out = torch.einsum("bsf,fd->bsd", h, w2) + b2
        return out

    x = A_x
    xn = _layernorm(x, axis=-1)
    s = _A_ref(xn, A_k_cache, A_v_cache, A_wq, A_wo)
    g = _silu(_B_ref(xn, B_w1, B_b1, B_w2, B_b2))
    return x + s * g
```

```asm
; @launch grid=(256,1,1) block=(512,1,1) lds=108544
.amdgcn_target "amdgcn-amd-amdhsa--gfx950"
.text
.globl recurrent_scan__sliding_block_cached__dense_activation_squared_relu__decode_kernel
.p2align 8
.type recurrent_scan__sliding_block_cached__dense_activation_squared_relu__decode_kernel,@function
recurrent_scan__sliding_block_cached__dense_activation_squared_relu__decode_kernel:
    s_load_dwordx16 s[4:19], s[0:1], 0
    s_getpc_b64 s[40:41]
    v_mul_u32_u24 v5, 20, v0
    global_load_dword v211, v5, s[40:41] offset:244
    s_load_dwordx4 s[20:23], s[0:1], 64
    s_load_dwordx2 s[24:25], s[0:1], 80
    s_load_dwordx2 s[26:27], s[0:1], 96
    v_lshrrev_b32 v1, 6, v0
    v_and_b32 v0, 63, v0
    s_lshr_b32 s31, s2, 3
    s_and_b32 s30, s2, 7
    v_readfirstlane_b32 s29, v1
    s_cmp_ge_u32 s31, 32
    s_cbranch_scc1 L_end
    v_and_b32 v1, 15, v0
    v_lshrrev_b32 v2, 4, v0
    s_and_b32 s40, s31, 7
    s_lshl_b32 s41, s30, 3
    s_add_u32 s40, s40, s41
    s_lshl_b32 s40, s40, 7
    s_and_b32 s41, s31, 24
    s_add_u32 s41, s41, s29
    s_lshl_b32 s41, s41, 17
    s_add_u32 s40, s40, s41
    v_and_b32 v4, 7, v0
    v_lshrrev_b32 v6, 3, v0
    v_and_b32 v7, 2, v6
    v_xor_b32 v7, v7, v4
    v_lshlrev_b32 v7, 4, v7
    v_lshl_add_u32 v8, v6, 13, v7
    v_xor_b32 v9, 64, v8
    v_add_u32 v9, 64512, v9
    s_lshl_b32 s41, s29, 11
    s_add_u32 m0, s41, 83968
    v_and_b32 v3, 1, v6
    v_lshl_add_u32 v5, v2, 3, v4
    v_lshlrev_b32 v5, 5, v5
    v_lshl_add_u32 v5, v3, 10, v5
    s_cmp_lt_u32 s29, 2
    s_waitcnt lgkmcnt(0)
    s_cbranch_scc0 L_nox
    global_load_dwordx4 v[16:19], v5, s[4:5]
    global_load_dwordx4 v[20:23], v5, s[4:5] offset:16
L_nox:
    s_add_u32 s10, s10, s40
    s_addc_u32 s11, s11, 0
    global_load_lds_dwordx4 v8, s[10:11] nt
    global_load_lds_dwordx4 v9, s[10:11] offset:1024 nt
    s_cmp_lt_u32 s29, 4
    s_cbranch_scc1 L_C
    s_lshr_b32 s34, s2, 7
    s_lshl_b32 s34, s34, 3
    s_add_u32 s34, s34, s30
    s_lshl_b32 s34, s34, 23
    s_and_b32 s35, s31, 15
    s_add_u32 s46, s2, s31
    s_and_b32 s46, s46, 3
    s_lshl_b32 s36, s46, 18
    s_add_u32 s34, s34, s36
    s_lshl_b32 s35, s35, 2
    s_add_u32 s35, s35, s29
    s_lshl_b32 s35, s35, 12
    s_add_u32 s34, s34, s35
    s_add_u32 s34, s34, 7323648
    v_lshlrev_b32 v14, 2, v2
    v_xor_b32 v14, v14, v1
    v_lshlrev_b32 v14, 4, v14
    v_lshl_add_u32 v4, v2, 8, v14
    v_xor_b32 v5, 16, v4
    v_xor_b32 v6, 32, v4
    v_xor_b32 v7, 48, v4
    s_lshl_b32 s36, s29, 14
    s_sub_u32 s36, s36, 47104
    s_add_u32 s6, s6, s34
    s_addc_u32 s7, s7, 0
    s_mov_b32 m0, s36
    s_add_u32 s36, s36, 4096
    global_load_lds_dwordx4 v4, s[6:7] offset:0 nt
    global_load_lds_dwordx4 v5, s[6:7] offset:1024 nt
    global_load_lds_dwordx4 v6, s[6:7] offset:2048 nt
    s_add_u32 s8, s8, s34
    s_addc_u32 s9, s9, 0
    s_sub_u32 s33, s29, 4
    v_lshlrev_b32 v3, 4, v0
    s_lshl_b32 s37, s33, 2
    v_mov_b32 v14, s37
    v_mov_b32 v15, 1
    s_barrier
    global_load_lds_dwordx4 v7, s[6:7] offset:3072 nt
    v_and_b32 v26, 3, v0
    v_lshlrev_b32 v26, 4, v26
    v_mov_b32 v12, 0xffff
    v_mov_b32 v13, 0
    v_lshlrev_b64 v[12:13], v26, v[12:13]
    s_lshl_b32 s38, s33, 10
    v_lshl_add_u32 v153, v0, 4, s38
    s_xor_b32 s45, s46, 1
    s_xor_b32 s44, s46, 0
    s_sub_i32 s44, s45, s44
    s_lshl_b32 s44, s44, 18
    s_ashr_i32 s45, s44, 31
    s_add_u32 s6, s6, s44
    s_addc_u32 s7, s7, s45
    s_mov_b32 m0, s36
    s_add_u32 s36, s36, 4096
    global_load_lds_dwordx4 v4, s[6:7] offset:0 nt
    s_lshl_b32 s38, s33, 11
    v_lshl_add_u32 v154, v0, 4, s38
    v_and_b32 v24, 1, v0
    v_lshlrev_b32 v24, 10, v24
    v_bfe_u32 v25, v0, 1, 4
    v_lshl_add_u32 v24, v25, 4, v24
    s_lshl_b32 s38, s33, 8
    global_load_lds_dwordx4 v5, s[6:7] offset:1024 nt
    v_add_u32 v155, s38, v24
    s_lshl_b32 s38, s30, 2
    s_add_u32 s38, s38, s33
    s_lshr_b32 s39, s31, 4
    s_and_b32 s40, s31, 7
    s_bfe_u32 s41, s31, 0x10003
    s_lshl_b32 s39, s39, 7
    s_waitcnt vmcnt(7)
    global_load_lds_dwordx4 v6, s[6:7] offset:2048 nt
    s_lshl_b32 s40, s40, 4
    s_add_u32 s39, s39, s40
    s_lshl_b32 s40, s38, 14
    s_lshl_b32 s42, s41, 10
    s_add_u32 s40, s40, s42
    s_add_u32 s40, s40, s39
    s_add_u32 s40, s40, 1048576
    s_waitcnt vmcnt(7)
    ds_write_b32 v14, v15 offset:1504
    global_load_lds_dwordx4 v7, s[6:7] offset:3072 nt
    v_bfe_u32 v24, v0, 2, 3
    v_lshlrev_b32 v24, 11, v24
    v_and_b32 v25, 3, v0
    v_lshl_add_u32 v24, v25, 8, v24
    v_add_u32 v156, s40, v24
    s_lshl_b32 s38, s38, 9
    s_lshl_b32 s41, s41, 8
    s_waitcnt vmcnt(7)
    s_xor_b32 s45, s46, 2
    s_xor_b32 s44, s46, 1
    s_sub_i32 s44, s45, s44
    s_lshl_b32 s44, s44, 18
    s_ashr_i32 s45, s44, 31
    s_add_u32 s6, s6, s44
    s_addc_u32 s7, s7, s45
    s_mov_b32 m0, s36
    s_add_u32 s36, s36, 4096
    global_load_lds_dwordx4 v4, s[6:7] offset:0 nt
    s_add_u32 s38, s38, s41
    s_add_u32 s38, s38, s39
    s_add_u32 s38, s38, 1572864
    v_mov_b32 v25, s38
    s_mov_b32 s42, -1
    s_mov_b32 s43, 0
    s_lshl_b32 s38, s30, 5
    s_waitcnt vmcnt(7)
    global_load_lds_dwordx4 v5, s[6:7] offset:1024 nt
    s_add_u32 s38, s38, s31
    v_cndmask_b32 v156, v25, v156, s[42:43]
    s_lshl_b32 s38, s38, 2
    s_add_u32 s38, s38, s33
    s_lshl_b32 s38, s38, 9
    s_add_u32 s38, s38, 1048576
    v_lshl_add_u32 v161, v0, 4, s38
    s_waitcnt vmcnt(7)
    global_load_lds_dwordx4 v6, s[6:7] offset:2048 nt
    v_cndmask_b32 v161, v25, v161, s[42:43]
    s_lshl_b32 s38, s33, 4
    v_mov_b32 v158, s38
    v_mov_b32 v160, 1023
    s_waitcnt vmcnt(7)
    global_load_lds_dwordx4 v7, s[6:7] offset:3072 nt
    s_waitcnt vmcnt(7)
    s_xor_b32 s45, s46, 3
    s_xor_b32 s44, s46, 2
    s_sub_i32 s44, s45, s44
    s_lshl_b32 s44, s44, 18
    s_ashr_i32 s45, s44, 31
    s_add_u32 s6, s6, s44
    s_addc_u32 s7, s7, s45
    s_mov_b32 m0, s36
    s_add_u32 s36, s36, 4096
    global_load_lds_dwordx4 v4, s[6:7] offset:0 nt
    s_waitcnt lgkmcnt(0)
    s_load_dword s28, s[26:27], 0
    s_waitcnt vmcnt(7)
    global_load_lds_dwordx4 v5, s[6:7] offset:1024 nt
    s_waitcnt vmcnt(7)
    global_load_lds_dwordx4 v6, s[6:7] offset:2048 nt
    s_waitcnt vmcnt(7)
    global_load_lds_dwordx4 v7, s[6:7] offset:3072 nt
    s_waitcnt vmcnt(7)
    global_load_dwordx4 v[32:35], v3, s[8:9] offset:0 nt
    s_waitcnt vmcnt(6)
    global_load_dwordx4 v[36:39], v3, s[8:9] offset:1024 nt
    s_waitcnt vmcnt(6)
    global_load_dwordx4 v[40:43], v3, s[8:9] offset:2048 nt
    ds_write_b32 v14, v15 offset:1408
    s_waitcnt vmcnt(6)
    global_load_dwordx4 v[44:47], v3, s[8:9] offset:3072 nt
    s_waitcnt vmcnt(6)
    s_xor_b32 s45, s46, 1
    s_xor_b32 s44, s46, 0
    s_sub_i32 s44, s45, s44
    s_lshl_b32 s44, s44, 18
    s_ashr_i32 s45, s44, 31
    s_add_u32 s8, s8, s44
    s_addc_u32 s9, s9, s45
    global_load_dwordx4 v[48:51], v3, s[8:9] offset:0 nt
    s_waitcnt vmcnt(6)
    global_load_dwordx4 v[52:55], v3, s[8:9] offset:1024 nt
    s_waitcnt vmcnt(6)
    s_waitcnt vmcnt(6)
    ds_write_b32 v14, v15 offset:1456
    global_load_dwordx4 v[56:59], v3, s[8:9] offset:2048 nt
    s_waitcnt vmcnt(6)
    global_load_dwordx4 v[60:63], v3, s[8:9] offset:3072 nt
    s_waitcnt vmcnt(6)
    s_xor_b32 s45, s46, 2
    s_xor_b32 s44, s46, 1
    s_sub_i32 s44, s45, s44
    s_lshl_b32 s44, s44, 18
    s_ashr_i32 s45, s44, 31
    s_add_u32 s8, s8, s44
    s_addc_u32 s9, s9, s45
    global_load_dwordx4 v[64:67], v3, s[8:9] offset:0 nt
    s_waitcnt vmcnt(6)
    global_load_dwordx4 v[68:71], v3, s[8:9] offset:1024 nt
    s_waitcnt vmcnt(6)
    global_load_dwordx4 v[72:75], v3, s[8:9] offset:2048 nt
    s_waitcnt vmcnt(6)
    global_load_dwordx4 v[76:79], v3, s[8:9] offset:3072 nt
    s_waitcnt vmcnt(6)
    s_xor_b32 s45, s46, 3
    s_xor_b32 s44, s46, 2
    s_sub_i32 s44, s45, s44
    s_lshl_b32 s44, s44, 18
    s_ashr_i32 s45, s44, 31
    s_add_u32 s8, s8, s44
    s_addc_u32 s9, s9, s45
    global_load_dwordx4 v[80:83], v3, s[8:9] offset:0 nt
    s_waitcnt vmcnt(6)
    global_load_dwordx4 v[84:87], v3, s[8:9] offset:1024 nt
    s_waitcnt vmcnt(6)
    global_load_dwordx4 v[88:91], v3, s[8:9] offset:2048 nt
    s_waitcnt vmcnt(6)
    global_load_dwordx4 v[92:95], v3, s[8:9] offset:3072 nt
    ds_write_b32 v14, v15 offset:1424
    s_add_u32 s48, s26, 8388608
    s_addc_u32 s49, s27, 0
    s_waitcnt lgkmcnt(0)
    s_add_u32 s28, s28, 1
    s_and_b32 s28, s28, 1023
    s_and_b32 s51, s28, 0xff
    s_getreg_b32 s50, hwreg(HW_REG_XCC_ID)
    s_lshl_b32 s50, s50, 10
    s_or_b32 s50, s50, s28
    v_mov_b32 v159, s28
    s_mov_b32 s36, 1069066811
L_wfP:
    ds_read_b32 v4, v14 offset:1472
    s_waitcnt lgkmcnt(0)
    v_readfirstlane_b32 s52, v4
    s_nop 0
    s_cmp_lg_u32 s52, 0
    s_cbranch_scc0 L_wfP
    s_mov_b32 s40, s52
    ds_read_b128 v[4:7], v153 offset:9728
    s_waitcnt lgkmcnt(0)
    v_and_b32_dpp v112, v4, v12 quad_perm:[0,0,0,0] row_mask:0xf bank_mask:0xf
    v_and_b32_dpp v113, v4, v13 quad_perm:[0,0,0,0] row_mask:0xf bank_mask:0xf
    v_and_b32_dpp v114, v4, v12 quad_perm:[1,1,1,1] row_mask:0xf bank_mask:0xf
    v_and_b32_dpp v115, v4, v13 quad_perm:[1,1,1,1] row_mask:0xf bank_mask:0xf
    v_and_b32_dpp v116, v4, v12 quad_perm:[2,2,2,2] row_mask:0xf bank_mask:0xf
    v_and_b32_dpp v117, v4, v13 quad_perm:[2,2,2,2] row_mask:0xf bank_mask:0xf
    v_and_b32_dpp v118, v4, v12 quad_perm:[3,3,3,3] row_mask:0xf bank_mask:0xf
    v_and_b32_dpp v119, v4, v13 quad_perm:[3,3,3,3] row_mask:0xf bank_mask:0xf
    v_and_b32_dpp v120, v5, v12 quad_perm:[0,0,0,0] row_mask:0xf bank_mask:0xf
    v_and_b32_dpp v121, v5, v13 quad_perm:[0,0,0,0] row_mask:0xf bank_mask:0xf
    v_and_b32_dpp v122, v5, v12 quad_perm:[1,1,1,1] row_mask:0xf bank_mask:0xf
    v_and_b32_dpp v123, v5, v13 quad_perm:[1,1,1,1] row_mask:0xf bank_mask:0xf
    v_and_b32_dpp v124, v5, v12 quad_perm:[2,2,2,2] row_mask:0xf bank_mask:0xf
    v_and_b32_dpp v125, v5, v13 quad_perm:[2,2,2,2] row_mask:0xf bank_mask:0xf
    v_and_b32_dpp v126, v5, v12 quad_perm:[3,3,3,3] row_mask:0xf bank_mask:0xf
    v_and_b32_dpp v127, v5, v13 quad_perm:[3,3,3,3] row_mask:0xf bank_mask:0xf
    v_and_b32_dpp v128, v6, v12 quad_perm:[0,0,0,0] row_mask:0xf bank_mask:0xf
    v_and_b32_dpp v129, v6, v13 quad_perm:[0,0,0,0] row_mask:0xf bank_mask:0xf
    v_and_b32_dpp v130, v6, v12 quad_perm:[1,1,1,1] row_mask:0xf bank_mask:0xf
    v_and_b32_dpp v131, v6, v13 quad_perm:[1,1,1,1] row_mask:0xf bank_mask:0xf
    v_and_b32_dpp v132, v6, v12 quad_perm:[2,2,2,2] row_mask:0xf bank_mask:0xf
    v_and_b32_dpp v133, v6, v13 quad_perm:[2,2,2,2] row_mask:0xf bank_mask:0xf
    v_and_b32_dpp v134, v6, v12 quad_perm:[3,3,3,3] row_mask:0xf bank_mask:0xf
    v_and_b32_dpp v135, v6, v13 quad_perm:[3,3,3,3] row_mask:0xf bank_mask:0xf
    v_and_b32_dpp v136, v7, v12 quad_perm:[0,0,0,0] row_mask:0xf bank_mask:0xf
    v_and_b32_dpp v137, v7, v13 quad_perm:[0,0,0,0] row_mask:0xf bank_mask:0xf
    v_and_b32_dpp v138, v7, v12 quad_perm:[1,1,1,1] row_mask:0xf bank_mask:0xf
    v_and_b32_dpp v139, v7, v13 quad_perm:[1,1,1,1] row_mask:0xf bank_mask:0xf
    v_and_b32_dpp v140, v7, v12 quad_perm:[2,2,2,2] row_mask:0xf bank_mask:0xf
    v_and_b32_dpp v141, v7, v13 quad_perm:[2,2,2,2] row_mask:0xf bank_mask:0xf
    v_and_b32_dpp v142, v7, v12 quad_perm:[3,3,3,3] row_mask:0xf bank_mask:0xf
    v_and_b32_dpp v143, v7, v13 quad_perm:[3,3,3,3] row_mask:0xf bank_mask:0xf
    s_waitcnt vmcnt(15)
    v_mfma_f32_16x16x16_bf16 v[144:147], v[112:113], v[32:33], 0
    v_mfma_f32_16x16x16_bf16 v[148:151], v[112:113], v[34:35], 0
    s_waitcnt vmcnt(14)
    v_mfma_f32_16x16x16_bf16 v[144:147], v[114:115], v[36:37], v[144:147]
    v_mfma_f32_16x16x16_bf16 v[148:151], v[114:115], v[38:39], v[148:151]
    s_waitcnt vmcnt(13)
    v_mfma_f32_16x16x16_bf16 v[144:147], v[116:117], v[40:41], v[144:147]
    v_mfma_f32_16x16x16_bf16 v[148:151], v[116:117], v[42:43], v[148:151]
    s_waitcnt vmcnt(12)
    v_mfma_f32_16x16x16_bf16 v[144:147], v[118:119], v[44:45], v[144:147]
    v_mfma_f32_16x16x16_bf16 v[148:151], v[118:119], v[46:47], v[148:151]
    s_waitcnt vmcnt(11)
    v_mfma_f32_16x16x16_bf16 v[144:147], v[120:121], v[48:49], v[144:147]
    v_mfma_f32_16x16x16_bf16 v[148:151], v[120:121], v[50:51], v[148:151]
    s_waitcnt vmcnt(10)
    v_mfma_f32_16x16x16_bf16 v[144:147], v[122:123], v[52:53], v[144:147]
    v_mfma_f32_16x16x16_bf16 v[148:151], v[122:123], v[54:55], v[148:151]
    s_waitcnt vmcnt(9)
    v_mfma_f32_16x16x16_bf16 v[144:147], v[124:125], v[56:57], v[144:147]
    v_mfma_f32_16x16x16_bf16 v[148:151], v[124:125], v[58:59], v[148:151]
    s_waitcnt vmcnt(8)
    v_mfma_f32_16x16x16_bf16 v[144:147], v[126:127], v[60:61], v[144:147]
    v_mfma_f32_16x16x16_bf16 v[148:151], v[126:127], v[62:63], v[148:151]
    s_waitcnt vmcnt(7)
    v_mfma_f32_16x16x16_bf16 v[144:147], v[128:129], v[64:65], v[144:147]
    v_mfma_f32_16x16x16_bf16 v[148:151], v[128:129], v[66:67], v[148:151]
    s_waitcnt vmcnt(6)
    v_mfma_f32_16x16x16_bf16 v[144:147], v[130:131], v[68:69], v[144:147]
    v_mfma_f32_16x16x16_bf16 v[148:151], v[130:131], v[70:71], v[148:151]
    v_mov_b32 v8, 0
L_wfP4:
    ds_read_b128 v[4:7], v8 offset:1472
    s_waitcnt lgkmcnt(0)
    v_and_b32 v4, v4, v5
    v_and_b32 v6, v6, v7
    v_and_b32 v4, v4, v6
    s_nop 0
    v_readfirstlane_b32 s52, v4
    s_nop 0
    s_cmp_lg_u32 s52, 0
    s_cbranch_scc0 L_wfP4
    ds_read_b128 v[16:19], v158 offset:1280
    ds_read_b128 v[20:23], v158 offset:1344
    s_waitcnt lgkmcnt(1)
    v_max3_f32 v24, v16, v17, v18
    v_max_f32 v24, v24, v19
    v_mul_f32 v25, 3216550459, v24
    v_fma_f32 v16, v16, s36, v25
    v_fma_f32 v17, v17, s36, v25
    v_fma_f32 v18, v18, s36, v25
    v_fma_f32 v19, v19, s36, v25
    v_exp_f32 v8, v16
    v_exp_f32 v10, v17
    v_exp_f32 v12, v18
    v_exp_f32 v14, v19
    s_waitcnt lgkmcnt(0)
    v_mul_f32 v25, v20, v8
    v_fmac_f32 v25, v21, v10
    v_fmac_f32 v25, v22, v12
    v_fmac_f32 v25, v23, v14
    s_waitcnt vmcnt(5)
    v_mfma_f32_16x16x16_bf16 v[144:147], v[132:133], v[72:73], v[144:147]
    v_mfma_f32_16x16x16_bf16 v[148:151], v[132:133], v[74:75], v[148:151]
    s_waitcnt vmcnt(4)
    v_mfma_f32_16x16x16_bf16 v[144:147], v[134:135], v[76:77], v[144:147]
    v_mfma_f32_16x16x16_bf16 v[148:151], v[134:135], v[78:79], v[148:151]
    s_waitcnt vmcnt(3)
    v_mfma_f32_16x16x16_bf16 v[144:147], v[136:137], v[80:81], v[144:147]
    v_mfma_f32_16x16x16_bf16 v[148:151], v[136:137], v[82:83], v[148:151]
    s_waitcnt vmcnt(2)
    v_mfma_f32_16x16x16_bf16 v[144:147], v[138:139], v[84:85], v[144:147]
    v_mfma_f32_16x16x16_bf16 v[148:151], v[138:139], v[86:87], v[148:151]
    s_waitcnt vmcnt(1)
    v_mfma_f32_16x16x16_bf16 v[144:147], v[140:141], v[88:89], v[144:147]
    v_mfma_f32_16x16x16_bf16 v[148:151], v[140:141], v[90:91], v[148:151]
    s_waitcnt vmcnt(0)
    v_mfma_f32_16x16x16_bf16 v[144:147], v[142:143], v[92:93], v[144:147]
    v_mfma_f32_16x16x16_bf16 v[148:151], v[142:143], v[94:95], v[148:151]
    s_nop 6
    ds_write_b128 v154, v[144:147] offset:1536
    ds_write_b128 v154, v[148:151] offset:2560
    s_waitcnt lgkmcnt(0)
    s_barrier
    ds_read_b128 v[96:99], v155 offset:1536
    ds_read_b128 v[100:103], v155 offset:3584
    ds_read_b128 v[104:107], v155 offset:5632
    ds_read_b128 v[108:111], v155 offset:7680
    s_waitcnt lgkmcnt(3)
    v_pk_mul_f32 v[96:97], v[96:97], v[8:9] op_sel_hi:[1,0]
    v_pk_mul_f32 v[98:99], v[98:99], v[8:9] op_sel_hi:[1,0]
    s_waitcnt lgkmcnt(2)
    v_pk_fma_f32 v[96:97], v[100:101], v[10:11], v[96:97] op_sel_hi:[1,0,1]
    v_pk_fma_f32 v[98:99], v[102:103], v[10:11], v[98:99] op_sel_hi:[1,0,1]
    s_waitcnt lgkmcnt(1)
    v_pk_fma_f32 v[96:97], v[104:105], v[12:13], v[96:97] op_sel_hi:[1,0,1]
    v_pk_fma_f32 v[98:99], v[106:107], v[12:13], v[98:99] op_sel_hi:[1,0,1]
    s_waitcnt lgkmcnt(0)
    v_pk_fma_f32 v[96:97], v[108:109], v[14:15], v[96:97] op_sel_hi:[1,0,1]
    v_pk_fma_f32 v[98:99], v[110:111], v[14:15], v[98:99] op_sel_hi:[1,0,1]
    v_cndmask_b32 v96, v24, v96, s[42:43]
    v_cndmask_b32 v97, v25, v97, s[42:43]
    v_bfi_b32 v96, v160, v159, v96
    v_bfi_b32 v97, v160, v159, v97
    v_bfi_b32 v98, v160, v159, v98
    v_bfi_b32 v99, v160, v159, v99
    s_mov_b32 exec_hi, 1
    global_store_dwordx4 v156, v[96:99], s[26:27]
    s_cmp_eq_u32 s40, 1
    s_cbranch_scc1 L_Snob
    global_store_dwordx4 v161, v[96:99], s[48:49] sc1
L_Snob:
L_end:
    s_endpgm
.p2align 8
L_C:
    s_cmp_ge_u32 s29, 2
    s_cbranch_scc1 L_Cnoffn
    s_cmp_eq_u32 s29, 0
    s_cbranch_scc1 L_Cwdone
    s_cmp_eq_u32 s30, 7
    s_cbranch_scc1 L_Cnoffn
    s_lshr_b32 s40, s31, 2
    s_mul_i32 s39, s40, 229376
    s_and_b32 s41, s31, 3
    s_lshl_b32 s42, s30, 2
    s_add_u32 s41, s41, s42
    s_lshl_b32 s42, s41, 7
    s_add_u32 s39, s39, s42
    v_mul_u32_u24 v8, 3584, v6
    v_xor_b32 v9, 64, v7
    v_add_u32 v9, v9, v8
    v_add_u32 v9, 27648, v9
    v_add_u32 v8, v8, v7
    s_add_u32 s16, s16, s39
    s_addc_u32 s17, s17, 0
    s_mov_b32 m0, 100352
    s_nop 0
    global_load_lds_dwordx4 v8, s[16:17] nt
    global_load_lds_dwordx4 v9, s[16:17] offset:1024 nt
    s_mov_b32 m0, 102400
    s_add_u32 s16, s16, 57344
    s_addc_u32 s17, s17, 0
    global_load_lds_dwordx4 v8, s[16:17] nt
    global_load_lds_dwordx4 v9, s[16:17] offset:1024 nt
    s_mov_b32 m0, 104448
    s_add_u32 s16, s16, 57344
    s_addc_u32 s17, s17, 0
    global_load_lds_dwordx4 v8, s[16:17] nt
    global_load_lds_dwordx4 v9, s[16:17] offset:1024 nt
    s_mov_b32 m0, 106496
    s_add_u32 s16, s16, 57344
    s_addc_u32 s17, s17, 0
    global_load_lds_dwordx4 v8, s[16:17] nt
    global_load_lds_dwordx4 v9, s[16:17] offset:1024 nt
L_Cwdone:
    s_load_dword s28, s[26:27], 0
    s_barrier
    v_mov_b32 v184, v5
    s_cmp_eq_u32 s29, 1
    s_cbranch_scc1 L_Cp1
    s_lshr_b32 s40, s31, 3
    s_lshl_b32 s34, s40, 8
    s_mov_b32 s35, 83968
    s_bfe_u32 s41, s31, 0x20001
    s_lshl_b32 s42, s30, 2
    s_add_u32 s41, s41, s42
    s_lshl_b32 s41, s41, 2
    s_add_u32 s41, s41, s40
    s_lshl_b32 s41, s41, 1
    s_and_b32 s42, s31, 1
    s_add_u32 s41, s41, s42
    s_lshl_b32 s37, s41, 8
    s_add_u32 s37, s37, 65536
    s_mov_b32 s38, 65536
    s_branch L_Cpa
L_Cp1:
    s_lshl_b32 s34, s40, 7
    s_mov_b32 s35, 100352
    s_mul_i32 s37, s40, 7168
    s_lshl_b32 s41, s41, 8
    s_add_u32 s37, s37, s41
    s_add_u32 s37, s37, 327680
    s_mov_b32 s38, 57344
L_Cpa:
    v_bfe_u32 v5, v0, 1, 2
    v_lshl_add_u32 v5, v5, 2, v2
    v_lshl_add_u32 v9, v5, 4, s37
    v_and_b32 v5, 1, v0
    v_mad_u32_u24 v9, v5, s38, v9
    v_lshl_add_u32 v6, v2, 3, v4
    v_lshlrev_b32 v6, 3, v6
    v_lshl_add_u32 v185, v3, 10, v6
    v_add_u32 v185, s34, v185
    s_lshl_b32 s40, s29, 9
    v_lshl_add_u32 v186, v3, 8, v6
    v_add_u32 v186, s40, v186
    v_lshlrev_b32 v187, 8, v5
    v_lshl_add_u32 v187, v2, 4, v187
    v_add_u32 v187, s40, v187
    v_bfe_u32 v5, v0, 2, 2
    v_and_b32 v6, 3, v0
    v_lshlrev_b32 v6, 3, v6
    v_lshl_add_u32 v6, v5, 7, v6
    v_lshl_add_u32 v6, v2, 10, v6
    v_and_b32 v5, 2, v5
    v_lshl_add_u32 v6, v5, 4, v6
    v_and_b32 v5, 1, v2
    v_lshl_add_u32 v6, v5, 6, v6
    v_xor_b32 v7, 0, v6
    v_add_u32 v188, s35, v7
    v_xor_b32 v7, 32, v6
    v_add_u32 v189, s35, v7
    v_xor_b32 v7, 64, v6
    v_add_u32 v190, s35, v7
    v_xor_b32 v7, 96, v6
    v_add_u32 v191, s35, v7
    v_and_b32 v5, 2, v0
    v_cmp_ne_u32 s[54:55], 0, v5
    v_and_b32 v5, 4, v0
    v_cmp_ne_u32 s[56:57], 0, v5
    v_and_b32 v5, 3, v0
    v_lshlrev_b32 v5, 4, v5
    v_mov_b32 v6, 0xffff
    v_mov_b32 v7, 0
    v_lshlrev_b64 v[6:7], v5, v[6:7]
    v_cmp_gt_u32 vcc, 4, v4
    s_nop 1
    v_cndmask_b32 v10, 0, v6, vcc
    v_cndmask_b32 v11, 0, v7, vcc
    v_cndmask_b32 v12, v6, 0, vcc
    v_cndmask_b32 v13, v7, 0, vcc
    s_cmp_eq_u32 s29, 1
    s_cbranch_scc1 L_Cw8
    s_waitcnt vmcnt(2)
L_Cw8:
    s_waitcnt vmcnt(10)
L_Cw:
    ds_write_b128 v184, v[16:19] offset:1536
    ds_write_b128 v184, v[20:23] offset:1552
    ds_read_b64 v[24:25], v185 offset:1536
    v_lshlrev_b32 v32, 16, v16
    v_and_b32 v33, 0xffff0000, v16
    v_lshlrev_b32 v34, 16, v17
    v_and_b32 v35, 0xffff0000, v17
    v_lshlrev_b32 v36, 16, v18
    v_and_b32 v37, 0xffff0000, v18
    v_lshlrev_b32 v38, 16, v19
    v_and_b32 v39, 0xffff0000, v19
    v_lshlrev_b32 v40, 16, v20
    v_and_b32 v41, 0xffff0000, v20
    v_lshlrev_b32 v42, 16, v21
    v_and_b32 v43, 0xffff0000, v21
    v_lshlrev_b32 v44, 16, v22
    v_and_b32 v45, 0xffff0000, v22
    v_lshlrev_b32 v46, 16, v23
    v_and_b32 v47, 0xffff0000, v23
    v_add_f32 v5, v32, v33
    v_add_f32 v6, v34, v35
    v_add_f32 v5, v5, v36
    v_add_f32 v6, v6, v37
    v_add_f32 v5, v5, v38
    v_add_f32 v6, v6, v39
    v_add_f32 v5, v5, v40
    v_add_f32 v6, v6, v41
    v_add_f32 v5, v5, v42
    v_add_f32 v6, v6, v43
    v_add_f32 v5, v5, v44
    v_add_f32 v6, v6, v45
    v_add_f32 v5, v5, v46
    v_add_f32 v6, v6, v47
    v_add_f32 v5, v5, v6
    s_nop 1
    v_add_f32_dpp v5, v5, v5 quad_perm:[1,0,3,2] row_mask:0xf bank_mask:0xf
    s_nop 1
    v_add_f32_dpp v5, v5, v5 quad_perm:[2,3,0,1] row_mask:0xf bank_mask:0xf
    s_nop 1
    v_add_f32_dpp v5, v5, v5 row_half_mirror row_mask:0xf bank_mask:0xf
    v_mov_b32 v6, v5
    s_nop 1
    v_permlane16_swap_b32 v5, v6
    v_add_f32 v5, v5, v6
    v_mov_b32 v6, v5
    s_nop 1
    v_permlane32_swap_b32 v5, v6
    v_add_f32 v5, v5, v6
    v_mul_f32 v5, 0x3b000000, v5
    v_sub_f32 v32, v32, v5
    v_sub_f32 v33, v33, v5
    v_sub_f32 v34, v34, v5
    v_sub_f32 v35, v35, v5
    v_sub_f32 v36, v36, v5
    v_sub_f32 v37, v37, v5
    v_sub_f32 v38, v38, v5
    v_sub_f32 v39, v39, v5
    v_sub_f32 v40, v40, v5
    v_sub_f32 v41, v41, v5
    v_sub_f32 v42, v42, v5
    v_sub_f32 v43, v43, v5
    v_sub_f32 v44, v44, v5
    v_sub_f32 v45, v45, v5
    v_sub_f32 v46, v46, v5
    v_sub_f32 v47, v47, v5
    v_mul_f32 v6, v32, v32
    v_mul_f32 v7, v33, v33
    v_fmac_f32 v6, v34, v34
    v_fmac_f32 v7, v35, v35
    v_fmac_f32 v6, v36, v36
    v_fmac_f32 v7, v37, v37
    v_fmac_f32 v6, v38, v38
    v_fmac_f32 v7, v39, v39
    v_fmac_f32 v6, v40, v40
    v_fmac_f32 v7, v41, v41
    v_fmac_f32 v6, v42, v42
    v_fmac_f32 v7, v43, v43
    v_fmac_f32 v6, v44, v44
    v_fmac_f32 v7, v45, v45
    v_fmac_f32 v6, v46, v46
    v_fmac_f32 v7, v47, v47
    v_add_f32 v6, v6, v7
    s_nop 1
    v_add_f32_dpp v6, v6, v6 quad_perm:[1,0,3,2] row_mask:0xf bank_mask:0xf
    s_nop 1
    v_add_f32_dpp v6, v6, v6 quad_perm:[2,3,0,1] row_mask:0xf bank_mask:0xf
    s_nop 1
    v_add_f32_dpp v6, v6, v6 row_half_mirror row_mask:0xf bank_mask:0xf
    v_mov_b32 v7, v6
    s_nop 1
    v_permlane16_swap_b32 v6, v7
    v_add_f32 v6, v6, v7
    v_mov_b32 v7, v6
    s_nop 1
    v_permlane32_swap_b32 v6, v7
    v_add_f32 v6, v6, v7
    v_mul_f32 v6, 0x3b000000, v6
    v_cvt_pk_bf16_f32 v5, 0, v5
    v_cvt_pk_bf16_f32 v6, 0, v6
    v_add_f32 v6, 0x3727c5ac, v6
    v_cvt_pk_bf16_f32 v6, 0, v6
    v_sqrt_f32 v6, v6
    s_nop 0
    v_cvt_pk_bf16_f32 v6, 0, v6
    v_rcp_f32 v6, v6
    s_waitcnt lgkmcnt(0)
    v_lshlrev_b32 v32, 16, v24
    v_and_b32 v33, 0xffff0000, v24
    v_lshlrev_b32 v34, 16, v25
    v_and_b32 v35, 0xffff0000, v25
    v_sub_f32 v32, v32, v5
    v_sub_f32 v33, v33, v5
    v_sub_f32 v34, v34, v5
    v_sub_f32 v35, v35, v5
    v_cvt_pk_bf16_f32 v32, 0, v32
    v_cvt_pk_bf16_f32 v33, 0, v33
    v_cvt_pk_bf16_f32 v34, 0, v34
    v_cvt_pk_bf16_f32 v35, 0, v35
    v_mul_f32 v32, v32, v6
    v_mul_f32 v33, v33, v6
    v_mul_f32 v34, v34, v6
    v_mul_f32 v35, v35, v6
    v_cvt_pk_bf16_f32 v24, v32, v33
    v_cvt_pk_bf16_f32 v25, v34, v35
    ds_write_b64 v186, v[24:25] offset:3584
    ds_read_b128 v[48:51], v187 offset:3584
    ds_read_b128 v[52:55], v187 offset:3648
    ds_read_b128 v[56:59], v187 offset:3712
    ds_read_b128 v[60:63], v187 offset:3776
    s_add_u32 s48, s26, 8388608
    s_addc_u32 s49, s27, 0
    s_waitcnt lgkmcnt(0)
    s_add_u32 s28, s28, 1
    s_and_b32 s28, s28, 1023
    s_and_b32 s51, s28, 0xff
    s_getreg_b32 s50, hwreg(HW_REG_XCC_ID)
    s_lshl_b32 s50, s50, 10
    s_or_b32 s50, s50, s28
    v_mov_b32 v14, s28
    v_mov_b32 v15, 1023
    s_lshl_b32 s40, s29, 2
    v_mov_b32 v7, s40
    v_mov_b32 v8, 1
    s_waitcnt vmcnt(8)
    s_cmp_eq_u32 s29, 1
    s_cbranch_scc0 L_Cl1
    ds_write_b32 v7, v8 offset:1488
    s_waitcnt vmcnt(0)
    s_branch L_Cl0
L_Cl1:
    s_waitcnt vmcnt(0)
    ds_write_b32 v7, v8 offset:1488
L_wfW0:
    ds_read_b128 v[32:35], v7 offset:1488
    s_waitcnt lgkmcnt(0)
    v_and_b32 v32, v32, v33
    v_and_b32 v34, v34, v35
    v_and_b32 v32, v32, v34
    s_nop 0
    v_readfirstlane_b32 s52, v32
    s_nop 0
    s_cmp_lg_u32 s52, 0
    s_cbranch_scc0 L_wfW0
L_wfW1:
    ds_read_b128 v[32:35], v7 offset:1504
    s_waitcnt lgkmcnt(0)
    v_and_b32 v32, v32, v33
    v_and_b32 v34, v34, v35
    v_and_b32 v32, v32, v34
    s_nop 0
    v_readfirstlane_b32 s52, v32
    s_nop 0
    s_cmp_lg_u32 s52, 0
    s_cbranch_scc0 L_wfW1
L_Cl0:
    ds_read_b64_tr_b16 v[112:113], v188 offset:0
    ds_read_b64_tr_b16 v[114:115], v188 offset:512
    ds_read_b64_tr_b16 v[116:117], v189 offset:0
    ds_read_b64_tr_b16 v[118:119], v189 offset:512
    ds_read_b64_tr_b16 v[120:121], v190 offset:0
    ds_read_b64_tr_b16 v[122:123], v190 offset:512
    ds_read_b64_tr_b16 v[124:125], v191 offset:0
    ds_read_b64_tr_b16 v[126:127], v191 offset:512
    s_waitcnt lgkmcnt(6)
    v_mfma_f32_16x16x32_bf16 v[64:67], v[112:115], v[48:51], 0
    s_waitcnt lgkmcnt(4)
    v_mfma_f32_16x16x32_bf16 v[68:71], v[116:119], v[48:51], 0
    s_waitcnt lgkmcnt(2)
    v_mfma_f32_16x16x32_bf16 v[72:75], v[120:123], v[48:51], 0
    s_waitcnt lgkmcnt(0)
    v_mfma_f32_16x16x32_bf16 v[76:79], v[124:127], v[48:51], 0
    ds_read_b64_tr_b16 v[128:129], v188 offset:4096
    ds_read_b64_tr_b16 v[130:131], v188 offset:4608
    ds_read_b64_tr_b16 v[132:133], v189 offset:4096
    ds_read_b64_tr_b16 v[134:135], v189 offset:4608
    ds_read_b64_tr_b16 v[136:137], v190 offset:4096
    ds_read_b64_tr_b16 v[138:139], v190 offset:4608
    ds_read_b64_tr_b16 v[140:141], v191 offset:4096
    ds_read_b64_tr_b16 v[142:143], v191 offset:4608
    s_waitcnt lgkmcnt(6)
    v_mfma_f32_16x16x32_bf16 v[64:67], v[128:131], v[52:55], v[64:67]
    s_waitcnt lgkmcnt(4)
    v_mfma_f32_16x16x32_bf16 v[68:71], v[132:135], v[52:55], v[68:71]
    s_waitcnt lgkmcnt(2)
    v_mfma_f32_16x16x32_bf16 v[72:75], v[136:139], v[52:55], v[72:75]
    s_waitcnt lgkmcnt(0)
    v_mfma_f32_16x16x32_bf16 v[76:79], v[140:143], v[52:55], v[76:79]
    s_cmp_eq_u32 s29, 1
    s_cbranch_scc1 L_Cm8
    ds_read_b64_tr_b16 v[144:145], v188 offset:8192
    ds_read_b64_tr_b16 v[146:147], v188 offset:8704
    ds_read_b64_tr_b16 v[148:149], v189 offset:8192
    ds_read_b64_tr_b16 v[150:151], v189 offset:8704
    ds_read_b64_tr_b16 v[152:153], v190 offset:8192
    ds_read_b64_tr_b16 v[154:155], v190 offset:8704
    ds_read_b64_tr_b16 v[156:157], v191 offset:8192
    ds_read_b64_tr_b16 v[158:159], v191 offset:8704
    s_waitcnt lgkmcnt(6)
    v_mfma_f32_16x16x32_bf16 v[64:67], v[144:147], v[56:59], v[64:67]
    s_waitcnt lgkmcnt(4)
    v_mfma_f32_16x16x32_bf16 v[68:71], v[148:151], v[56:59], v[68:71]
    s_waitcnt lgkmcnt(2)
    v_mfma_f32_16x16x32_bf16 v[72:75], v[152:155], v[56:59], v[72:75]
    s_waitcnt lgkmcnt(0)
    v_mfma_f32_16x16x32_bf16 v[76:79], v[156:159], v[56:59], v[76:79]
    ds_read_b64_tr_b16 v[160:161], v188 offset:12288
    ds_read_b64_tr_b16 v[162:163], v188 offset:12800
    ds_read_b64_tr_b16 v[164:165], v189 offset:12288
    ds_read_b64_tr_b16 v[166:167], v189 offset:12800
    ds_read_b64_tr_b16 v[168:169], v190 offset:12288
    ds_read_b64_tr_b16 v[170:171], v190 offset:12800
    ds_read_b64_tr_b16 v[172:173], v191 offset:12288
    ds_read_b64_tr_b16 v[174:175], v191 offset:12800
    s_waitcnt lgkmcnt(6)
    v_mfma_f32_16x16x32_bf16 v[64:67], v[160:163], v[60:63], v[64:67]
    s_waitcnt lgkmcnt(4)
    v_mfma_f32_16x16x32_bf16 v[68:71], v[164:167], v[60:63], v[68:71]
    s_waitcnt lgkmcnt(2)
    v_mfma_f32_16x16x32_bf16 v[72:75], v[168:171], v[60:63], v[72:75]
    s_waitcnt lgkmcnt(0)
    v_mfma_f32_16x16x32_bf16 v[76:79], v[172:175], v[60:63], v[76:79]
L_Cm8:
    s_nop 7
    v_cndmask_b32 v64, v64, v68, s[54:55]
    v_cndmask_b32 v72, v72, v76, s[54:55]
    v_cndmask_b32 v65, v65, v69, s[54:55]
    v_cndmask_b32 v73, v73, v77, s[54:55]
    v_cndmask_b32 v66, v66, v70, s[54:55]
    v_cndmask_b32 v74, v74, v78, s[54:55]
    v_cndmask_b32 v67, v67, v71, s[54:55]
    v_cndmask_b32 v75, v75, v79, s[54:55]
    v_cndmask_b32 v176, v64, v72, s[56:57]
    v_cndmask_b32 v177, v65, v73, s[56:57]
    v_cndmask_b32 v178, v66, v74, s[56:57]
    v_cndmask_b32 v179, v67, v75, s[56:57]
    v_mov_b32 v5, 0xff
    v_add_u32 v176, 0x80, v176
    v_add_u32 v177, 0x80, v177
    v_add_u32 v178, 0x80, v178
    v_add_u32 v179, 0x80, v179
    v_bfi_b32 v176, v5, v14, v176
    v_bfi_b32 v177, v5, v14, v177
    v_bfi_b32 v178, v5, v14, v178
    v_bfi_b32 v179, v5, v14, v179
    s_mov_b32 exec_lo, 0x00ff00ff
    s_mov_b32 exec_hi, 0x00ff00ff
    global_store_dwordx4 v9, v[176:179], s[26:27]
    s_mov_b64 exec, -1
    v_mov_b32 v182, v9
    s_branch L_Cmid
L_Cnoffn:
    v_mov_b32 v9, 0
    v_mov_b32 v182, 0
    v_mov_b32 v5, 0
    v_and_b32 v6, 31, v0
    v_lshlrev_b32 v6, 2, v6
    ds_write_b32 v6, v5 offset:1408
    s_waitcnt lgkmcnt(0)
    s_load_dword s28, s[26:27], 0
    s_barrier
    s_add_u32 s48, s26, 8388608
    s_addc_u32 s49, s27, 0
    s_waitcnt lgkmcnt(0)
    s_add_u32 s28, s28, 1
    s_and_b32 s28, s28, 1023
    s_and_b32 s51, s28, 0xff
    s_getreg_b32 s50, hwreg(HW_REG_XCC_ID)
    s_lshl_b32 s50, s50, 10
    s_or_b32 s50, s50, s28
    v_mov_b32 v14, s28
    v_mov_b32 v15, 1023
    s_lshl_b32 s40, s29, 2
    v_mov_b32 v7, s40
    v_mov_b32 v8, 1
    s_cmp_eq_u32 s29, 3
    s_cbranch_scc1 L_Cid
    s_waitcnt vmcnt(0)
    s_branch L_Cnoid
L_Cid:
    s_lshl_b32 s40, s30, 5
    s_add_u32 s40, s40, s31
    s_lshl_b32 s40, s40, 2
    s_add_u32 s40, s40, 4096
    v_mov_b32 v5, s40
    v_mov_b32 v6, s50
    s_mov_b64 exec, 1
    global_store_dword v5, v6, s[26:27]
    s_mov_b64 exec, -1
L_Cnoid:
    s_waitcnt vmcnt(1)
    ds_write_b32 v7, v8 offset:1488
    v_and_b32 v5, 3, v0
    v_lshlrev_b32 v5, 4, v5
    v_mov_b32 v6, 0xffff
    v_mov_b32 v7, 0
    v_lshlrev_b64 v[6:7], v5, v[6:7]
    v_cmp_gt_u32 vcc, 4, v4
    s_nop 1
    v_cndmask_b32 v10, 0, v6, vcc
    v_cndmask_b32 v11, 0, v7, vcc
    v_cndmask_b32 v12, v6, 0, vcc
    v_cndmask_b32 v13, v7, 0, vcc
L_Cmid:
    s_cmp_lt_u32 s30, 7
    s_cselect_b32 s45, 2, 0
    s_cmp_lt_u32 s29, s45
    s_cselect_b32 s45, 1, 0
    s_lshr_b32 s40, s31, 4
    s_lshl_b32 s40, s40, 5
    s_lshl_b32 s41, s30, 2
    s_add_u32 s40, s40, s41
    s_add_u32 s40, s40, s29
    s_lshl_b32 s40, s40, 11
    s_add_u32 s40, s40, 65536
    v_lshl_add_u32 v100, v0, 4, s40
    s_mul_i32 s40, s29, 272
    v_and_b32 v5, 31, v0
    v_lshl_add_u32 v101, v5, 3, s40
    v_lshrrev_b32 v6, 5, v0
    v_lshl_add_u32 v101, v6, 2, v101
    s_lshl_b32 s40, s30, 7
    s_add_u32 s40, s40, 4096
    v_lshl_add_u32 v102, v5, 2, s40
    v_and_b32 v5, 3, v1
    v_lshlrev_b32 v5, 10, v5
    v_lshrrev_b32 v6, 2, v1
    v_lshl_add_u32 v5, v6, 8, v5
    s_lshl_b32 s40, s29, 14
    s_add_u32 s40, s40, 18432
    v_add_u32 v5, s40, v5
    v_add_u32 v7, 0, v2
    v_xor_b32 v7, v7, v1
    v_lshl_add_u32 v96, v7, 4, v5
    v_add_u32 v7, 4, v2
    v_xor_b32 v7, v7, v1
    v_lshl_add_u32 v97, v7, 4, v5
    v_add_u32 v7, 8, v2
    v_xor_b32 v7, v7, v1
    v_lshl_add_u32 v98, v7, 4, v5
    v_add_u32 v7, 12, v2
    v_xor_b32 v7, v7, v1
    v_lshl_add_u32 v99, v7, 4, v5
    v_mul_u32_u24 v103, 272, v6
    v_lshl_add_u32 v103, v2, 4, v103
    s_lshl_b32 s40, s29, 2
    v_lshl_add_u32 v104, v6, 4, s40
    v_mov_b32 v107, s40
    v_mov_b32 v106, 0
    s_lshl_b32 s40, s29, 10
    v_lshl_add_u32 v105, v0, 4, s40
    v_and_b32 v5, 1, v0
    v_cmp_ne_u32 s[54:55], 0, v5
    v_and_b32 v5, 2, v0
    v_cmp_ne_u32 s[56:57], 0, v5
    s_lshl_b32 s40, s30, 3
    s_lshr_b32 s41, s31, 2
    s_add_u32 s40, s40, s41
    s_lshl_b32 s40, s40, 1
    s_add_u32 s40, s40, s29
    s_lshl_b32 s41, s40, 6
    s_add_u32 s41, s41, 327680
    v_mul_u32_u24 v6, 7168, v4
    v_lshl_add_u32 v6, v2, 4, v6
    v_add_u32 v6, s41, v6
    v_mul_u32_u24 v8, 57344, v3
    v_add_u32 v109, v6, v8
    v_add_u32 v110, 57344, v109
    s_lshl_b32 s41, s40, 5
    v_lshl_add_u32 v108, v2, 3, s41
    s_lshl_b32 s40, s30, 5
    s_add_u32 s40, s40, s31
    s_lshr_b32 s41, s40, 6
    s_lshl_b32 s41, s41, 7
    s_and_b32 s42, s40, 15
    s_lshl_b32 s42, s42, 3
    s_add_u32 s41, s41, s42
    s_bfe_u32 s42, s40, 0x10004
    s_lshl_b32 s42, s42, 2
    s_add_u32 s41, s41, s42
    s_bfe_u32 s42, s40, 0x10005
    s_lshl_b32 s42, s42, 9
    s_add_u32 s42, s42, s41
    s_and_b32 s43, s29, 1
    v_lshrrev_b32 v6, 5, v0
    v_lshl_add_u32 v6, s43, 1, v6
    v_add_lshl_u32 v202, v6, s42, 1
    v_add_lshl_u32 v7, v6, s41, 1
    global_load_ushort v200, v202, s[4:5]
    global_load_ushort v201, v7, s[22:23]
    s_and_b32 s40, s31, 3
    s_lshl_b32 s40, s40, 8
    s_lshr_b32 s41, s31, 2
    s_lshl_b32 s42, s30, 3
    s_add_u32 s47, s42, s41
    s_lshl_b32 s42, s47, 1
    s_add_u32 s42, s42, s29
    s_lshl_b32 s42, s42, 14
    s_add_u32 s42, s42, s40
    s_add_u32 s20, s20, s42
    s_addc_u32 s21, s21, 0
    s_lshl_b32 s42, s47, 2
    s_add_u32 s42, s42, s29
    s_lshl_b32 s43, s42, 14
    s_add_u32 s43, s43, s40
    s_add_u32 s12, s12, s43
    s_addc_u32 s13, s13, 0
    v_lshlrev_b32 v205, 12, v2
    v_lshl_add_u32 v205, v1, 4, v205
    s_lshl_b32 s42, s42, 11
    s_add_u32 s42, s42, 1048576
    v_lshl_add_u32 v24, v0, 4, s42
    s_lshr_b32 s42, s47, 1
    s_lshl_b32 s42, s42, 9
    s_add_u32 s42, s42, 1572864
    v_lshl_add_u32 v26, v1, 4, s42
    s_lshl_b32 s42, s30, 16
    s_bfe_u32 s43, s31, 0x30002
    s_lshl_b32 s43, s43, 8
    s_add_u32 s42, s42, s43
    s_lshl_b32 s43, s29, 6
    s_add_u32 s42, s42, s43
    s_add_u32 s42, s42, 1048576
    v_lshl_add_u32 v7, v3, 4, v4
    v_lshlrev_b32 v7, 11, v7
    v_lshl_add_u32 v7, v2, 4, v7
    v_add_u32 v203, s42, v7
    v_add_u32 v204, 16384, v203
    s_and_b32 s40, s31, 3
    s_lshl_b32 s40, s40, 6
    s_add_u32 s40, s40, s47
    s_mul_i32 s40, s40, 2304
    s_lshl_b32 s41, s29, 10
    s_add_u32 s40, s40, s41
    s_add_u32 s40, s40, 2097152
    v_lshl_add_u32 v27, v0, 4, s40
    s_lshl_b32 s40, s30, 5
    s_add_u32 s40, s40, s31
    s_lshr_b32 s41, s40, 6
    s_mul_i32 s41, s41, 147456
    s_and_b32 s40, s40, 63
    s_lshl_b32 s40, s40, 5
    s_add_u32 s40, s40, s41
    s_add_u32 s40, s40, 2097152
    v_mul_u32_u24 v28, 2304, v0
    v_add_u32 v28, s40, v28
    v_add_u32 v29, 16, v28
    s_lshl_b32 s40, s29, 4
    v_add_u32 v28, s40, v28
    s_lshl_b32 s40, s29, 10
    v_lshl_add_u32 v30, v0, 4, s40
    v_lshlrev_b32 v31, 4, v0
    s_lshl_b32 s40, s29, 9
    s_add_u32 s40, s40, 9728
    v_lshl_add_u32 v31, v0, 3, s40
L_wfT:
    ds_read_b128 v[32:35], v106 offset:1408
    s_waitcnt lgkmcnt(0)
    v_and_b32 v32, v32, v33
    v_and_b32 v34, v34, v35
    v_and_b32 v32, v32, v34
    s_nop 0
    v_readfirstlane_b32 s52, v32
    s_nop 0
    s_cmp_lg_u32 s52, 0
    s_cbranch_scc0 L_wfT
    global_load_dword v111, v102, s[26:27] sc1 nt
    global_load_dwordx4 v[48:51], v100, s[26:27] offset:0 sc1 nt
    global_load_dwordx4 v[52:55], v100, s[26:27] offset:1024 sc1 nt
L_wfK:
    ds_read_b32 v32, v107 offset:1456
    s_waitcnt lgkmcnt(0)
    v_readfirstlane_b32 s52, v32
    s_nop 0
    s_cmp_lg_u32 s52, 0
    s_cbranch_scc0 L_wfK
    ds_read_b128 v[112:115], v96 offset:0
    ds_read_b128 v[116:119], v97 offset:0
    ds_read_b128 v[120:123], v98 offset:0
    ds_read_b128 v[124:127], v99 offset:0
    ds_read_b128 v[128:131], v96 offset:4096
    ds_read_b128 v[132:135], v97 offset:4096
    ds_read_b128 v[136:139], v98 offset:4096
    ds_read_b128 v[140:143], v99 offset:4096
    ds_read_b128 v[144:147], v96 offset:8192
    ds_read_b128 v[148:151], v97 offset:8192
    ds_read_b128 v[152:155], v98 offset:8192
    ds_read_b128 v[156:159], v99 offset:8192
    ds_read_b128 v[160:163], v96 offset:12288
    ds_read_b128 v[164:167], v97 offset:12288
    ds_read_b128 v[168:171], v98 offset:12288
    ds_read_b128 v[172:175], v99 offset:12288
    global_load_dwordx4 v[56:59], v100, s[26:27] offset:0 sc1 nt
    global_load_dwordx4 v[60:63], v100, s[26:27] offset:1024 sc1 nt
    s_waitcnt vmcnt(2)
    v_cmp_ne_u32 vcc, s50, v111
    s_mov_b32 s53, 1
    s_cbranch_vccz L_Cnob
    s_mov_b32 s53, 3
    s_cmp_eq_u32 s29, 0
    s_cselect_b32 s40, 1, s45
    s_cmp_eq_u32 s40, 0
    s_cbranch_scc1 L_Cnob
    s_mov_b32 exec_lo, 0x00ff00ff
    s_mov_b32 exec_hi, 0x00ff00ff
    global_store_dwordx4 v182, v[176:179], s[48:49] sc1
    s_mov_b64 exec, -1
L_Cnob:
    s_mov_b32 s46, 0
    s_waitcnt vmcnt(63)
    s_branch L_pollQ_f
L_pollQ:
    global_load_dwordx4 v[48:51], v100, s[26:27] offset:0 sc1 nt
    global_load_dwordx4 v[52:55], v100, s[26:27] offset:1024 sc1 nt
L_pollQ_c:
    s_waitcnt vmcnt(0)
L_pollQ_f:
    v_xor_b32 v48, s51, v48
    v_xor_b32 v49, s51, v49
    v_xor_b32 v50, s51, v50
    v_xor_b32 v51, s51, v51
    v_xor_b32 v52, s51, v52
    v_xor_b32 v53, s51, v53
    v_xor_b32 v54, s51, v54
    v_xor_b32 v55, s51, v55
    v_or3_b32 v7, v48, v49, v50
    v_or3_b32 v7, v7, v51, v52
    v_or3_b32 v7, v7, v53, v54
    v_or_b32 v7, v7, v55
    v_and_b32 v7, 255, v7
    v_cmp_ne_u32 vcc, 0, v7
    s_nop 0
    s_and_b64 exec, exec, vcc
    s_cbranch_scc0 L_pollQ_x
    s_add_u32 s46, s46, 1
    s_cmp_gt_u32 s46, 200000
    s_cbranch_scc1 L_pollQ_x
    s_cmp_eq_u32 s46, 1
    s_cbranch_scc0 L_pollQ_n
    s_waitcnt vmcnt(0)
    v_mov_b32 v48, v56
    v_mov_b32 v49, v57
    v_mov_b32 v50, v58
    v_mov_b32 v51, v59
    v_mov_b32 v52, v60
    v_mov_b32 v53, v61
    v_mov_b32 v54, v62
    v_mov_b32 v55, v63
    s_branch L_pollQ_f
L_pollQ_n:
    s_cmp_eq_u32 s53, 1
    s_cbranch_scc1 L_pollQ
    s_and_b32 s52, s46, 1
    s_cbranch_scc0 L_pollQ
    global_load_dwordx4 v[48:51], v100, s[48:49] offset:0 sc1
    global_load_dwordx4 v[52:55], v100, s[48:49] offset:1024 sc1
    s_branch L_pollQ_c
L_pollQ_x:
    s_mov_b64 exec, -1
    v_add_f32 v48, v48, v52
    v_add_f32 v49, v49, v53
    v_add_f32 v50, v50, v54
    v_add_f32 v51, v51, v55
    s_nop 0
    v_permlane32_swap_b32 v48, v50
    v_permlane32_swap_b32 v49, v51
    v_add_f32 v48, v48, v50
    v_add_f32 v49, v49, v51
    v_cvt_pk_bf16_f32 v5, v48, v49
    ds_write_b32 v101, v5 offset:0
    v_mov_b32 v6, s53
    s_waitcnt lgkmcnt(0)
    ds_write_b32 v107, v6 offset:1440
    v_mov_b32 v176, 0
    v_mov_b32 v177, 0
    v_mov_b32 v178, 0
    v_mov_b32 v179, 0
    s_cmp_eq_u32 s45, 0
    s_cbranch_scc1 L_Cnoh
    global_load_dwordx4 v[16:19], v109, s[26:27] offset:0 sc1 nt
    global_load_dwordx2 v[180:181], v108, s[18:19]
L_Cnoh:
L_wfq:
    ds_read_b128 v[32:35], v106 offset:1440
    s_waitcnt lgkmcnt(0)
    v_and_b32 v32, v32, v33
    v_and_b32 v34, v34, v35
    v_and_b32 v32, v32, v34
    s_nop 0
    v_readfirstlane_b32 s52, v32
    s_nop 0
    s_cmp_lg_u32 s52, 0
    s_cbranch_scc0 L_wfq
    ds_read_b128 v[64:67], v103 offset:0
    ds_read_b128 v[68:71], v103 offset:64
    ds_read_b128 v[72:75], v103 offset:128
    ds_read_b128 v[76:79], v103 offset:192
    s_waitcnt lgkmcnt(3)
    v_mfma_f32_16x16x32_bf16 v[80:83], v[112:115], v[64:67], 0
    v_mfma_f32_16x16x32_bf16 v[84:87], v[128:131], v[64:67], 0
    v_mfma_f32_16x16x32_bf16 v[88:91], v[144:147], v[64:67], 0
    v_mfma_f32_16x16x32_bf16 v[92:95], v[160:163], v[64:67], 0
    s_waitcnt lgkmcnt(2)
    v_mfma_f32_16x16x32_bf16 v[80:83], v[116:119], v[68:71], v[80:83]
    v_mfma_f32_16x16x32_bf16 v[84:87], v[132:135], v[68:71], v[84:87]
    v_mfma_f32_16x16x32_bf16 v[88:91], v[148:151], v[68:71], v[88:91]
    v_mfma_f32_16x16x32_bf16 v[92:95], v[164:167], v[68:71], v[92:95]
    s_waitcnt lgkmcnt(1)
    v_mfma_f32_16x16x32_bf16 v[80:83], v[120:123], v[72:75], v[80:83]
    v_mfma_f32_16x16x32_bf16 v[84:87], v[136:139], v[72:75], v[84:87]
    v_mfma_f32_16x16x32_bf16 v[88:91], v[152:155], v[72:75], v[88:91]
    v_mfma_f32_16x16x32_bf16 v[92:95], v[168:171], v[72:75], v[92:95]
    s_waitcnt lgkmcnt(0)
    v_mfma_f32_16x16x32_bf16 v[80:83], v[124:127], v[76:79], v[80:83]
    v_mfma_f32_16x16x32_bf16 v[84:87], v[140:143], v[76:79], v[84:87]
    v_mfma_f32_16x16x32_bf16 v[88:91], v[156:159], v[76:79], v[88:91]
    v_mfma_f32_16x16x32_bf16 v[92:95], v[172:175], v[76:79], v[92:95]
    s_nop 4
    v_cndmask_b32 v80, v80, v81, s[54:55]
    v_cndmask_b32 v82, v82, v83, s[54:55]
    v_cndmask_b32 v84, v84, v85, s[54:55]
    v_cndmask_b32 v86, v86, v87, s[54:55]
    v_cndmask_b32 v88, v88, v89, s[54:55]
    v_cndmask_b32 v90, v90, v91, s[54:55]
    v_cndmask_b32 v92, v92, v93, s[54:55]
    v_cndmask_b32 v94, v94, v95, s[54:55]
    v_cndmask_b32 v32, v80, v82, s[56:57]
    v_cndmask_b32 v33, v84, v86, s[56:57]
    v_cndmask_b32 v34, v88, v90, s[56:57]
    v_cndmask_b32 v35, v92, v94, s[56:57]
    v_cvt_pk_bf16_f32 v32, 0, v32
    v_cvt_pk_bf16_f32 v33, 0, v33
    v_cvt_pk_bf16_f32 v34, 0, v34
    v_cvt_pk_bf16_f32 v35, 0, v35
    v_mul_f32 v32, 1035273459, v32
    v_mul_f32 v33, 1035273459, v33
    v_mul_f32 v34, 1035273459, v34
    v_mul_f32 v35, 1035273459, v35
    v_cvt_pk_bf16_f32 v32, 0, v32
    v_cvt_pk_bf16_f32 v33, 0, v33
    v_cvt_pk_bf16_f32 v34, 0, v34
    v_cvt_pk_bf16_f32 v35, 0, v35
    v_max3_f32 v8, v32, v33, v34
    v_max_f32 v8, v8, v35
    s_nop 1
    v_max_f32_dpp v8, v8, v8 quad_perm:[1,0,3,2] row_mask:0xf bank_mask:0xf
    s_nop 1
    v_max_f32_dpp v8, v8, v8 quad_perm:[2,3,0,1] row_mask:0xf bank_mask:0xf
    v_mov_b32 v9, v8
    s_nop 1
    v_permlane16_swap_b32 v8, v9
    v_max_f32 v8, v8, v9
    v_mov_b32 v9, v8
    s_nop 1
    v_permlane32_swap_b32 v8, v9
    v_max_f32 v8, v8, v9
    ds_write_b32 v104, v8 offset:1280
    v_mul_f32 v9, 3216550459, v8
    s_mov_b32 s40, 1069066811
    v_fma_f32 v32, v32, s40, v9
    v_fma_f32 v33, v33, s40, v9
    v_fma_f32 v34, v34, s40, v9
    v_fma_f32 v35, v35, s40, v9
    v_exp_f32 v32, v32
    v_exp_f32 v33, v33
    v_exp_f32 v34, v34
    v_exp_f32 v35, v35
    v_cvt_pk_bf16_f32 v80, v32, v32
    v_cvt_pk_bf16_f32 v81, v33, v33
    v_cvt_pk_bf16_f32 v82, v34, v34
    v_cvt_pk_bf16_f32 v83, v35, v35
    ds_write_b128 v105, v[80:83] offset:9728
    v_add_f32 v8, v32, v33
    v_add_f32 v9, v34, v35
    v_add_f32 v8, v8, v9
    s_nop 1
    v_add_f32_dpp v8, v8, v8 quad_perm:[1,0,3,2] row_mask:0xf bank_mask:0xf
    s_nop 1
    v_add_f32_dpp v8, v8, v8 quad_perm:[2,3,0,1] row_mask:0xf bank_mask:0xf
    v_mov_b32 v9, v8
    s_nop 1
    v_permlane16_swap_b32 v8, v9
    v_add_f32 v8, v8, v9
    v_mov_b32 v9, v8
    s_nop 1
    v_permlane32_swap_b32 v8, v9
    v_add_f32 v8, v8, v9
    ds_write_b32 v104, v8 offset:1344
    s_waitcnt lgkmcnt(0)
    ds_write_b32 v107, v6 offset:1472
    v_lshlrev_b32 v200, 16, v200
    v_lshlrev_b32 v201, 16, v201
L_wfV:
    ds_read_b128 v[32:35], v106 offset:1424
    s_waitcnt lgkmcnt(0)
    v_and_b32 v32, v32, v33
    v_and_b32 v34, v34, v35
    v_and_b32 v32, v32, v34
    s_nop 0
    v_readfirstlane_b32 s52, v32
    s_nop 0
    s_cmp_lg_u32 s52, 0
    s_cbranch_scc0 L_wfV
    global_load_dwordx4 v[152:155], v26, s[26:27] offset:0 sc1 nt
    global_load_dwordx4 v[156:159], v26, s[26:27] offset:256 sc1 nt
    global_load_dwordx4 v[144:147], v24, s[26:27] offset:0 sc1 nt
    global_load_dwordx4 v[148:151], v24, s[26:27] offset:1024 sc1 nt
    s_cmp_eq_u32 s45, 0
    s_cbranch_scc1 L_Cnow2
    global_load_dwordx4 v[112:115], v205, s[20:21] offset:0 nt
    global_load_dwordx4 v[116:119], v205, s[20:21] offset:1024 nt
    global_load_dwordx4 v[120:123], v205, s[20:21] offset:2048 nt
    global_load_dwordx4 v[124:127], v205, s[20:21] offset:3072 nt
L_Cnow2:
    global_load_dwordx4 v[128:131], v205, s[12:13] offset:0 nt
    global_load_dwordx4 v[132:135], v205, s[12:13] offset:1024 nt
    global_load_dwordx4 v[136:139], v205, s[12:13] offset:2048 nt
    global_load_dwordx4 v[140:143], v205, s[12:13] offset:3072 nt
    s_cmp_eq_u32 s45, 0
    s_cbranch_scc1 L_Cnoh2
    s_mov_b32 s46, 0
    s_waitcnt vmcnt(12)
    s_branch L_pollH_f
L_pollH:
    global_load_dwordx4 v[16:19], v109, s[26:27] offset:0 sc1 nt
L_pollH_c:
    s_waitcnt vmcnt(0)
L_pollH_f:
    v_xor_b32 v16, s51, v16
    v_xor_b32 v17, s51, v17
    v_xor_b32 v18, s51, v18
    v_xor_b32 v19, s51, v19
    v_or3_b32 v7, v16, v17, v18
    v_or_b32 v7, v7, v19
    v_and_b32 v7, 255, v7
    v_cmp_ne_u32 vcc, 0, v7
    s_nop 0
    s_and_b64 exec, exec, vcc
    s_cbranch_scc0 L_pollH_x
    s_add_u32 s46, s46, 1
    s_cmp_gt_u32 s46, 200000
    s_cbranch_scc1 L_pollH_x
    s_cmp_eq_u32 s53, 1
    s_cbranch_scc1 L_pollH
    s_and_b32 s52, s46, 1
    s_cbranch_scc0 L_pollH
    global_load_dwordx4 v[16:19], v109, s[48:49] offset:0 sc1
    s_branch L_pollH_c
L_pollH_x:
    s_mov_b64 exec, -1
    v_add_f32_dpp v16, v16, v16 quad_perm:[1,0,3,2] row_mask:0xf bank_mask:0xf
    v_add_f32_dpp v17, v17, v17 quad_perm:[1,0,3,2] row_mask:0xf bank_mask:0xf
    v_add_f32_dpp v18, v18, v18 quad_perm:[1,0,3,2] row_mask:0xf bank_mask:0xf
    v_add_f32_dpp v19, v19, v19 quad_perm:[1,0,3,2] row_mask:0xf bank_mask:0xf
    v_add_f32_dpp v16, v16, v16 quad_perm:[2,3,0,1] row_mask:0xf bank_mask:0xf
    v_add_f32_dpp v17, v17, v17 quad_perm:[2,3,0,1] row_mask:0xf bank_mask:0xf
    v_add_f32_dpp v18, v18, v18 quad_perm:[2,3,0,1] row_mask:0xf bank_mask:0xf
    v_add_f32_dpp v19, v19, v19 quad_perm:[2,3,0,1] row_mask:0xf bank_mask:0xf
    v_add_f32_dpp v16, v16, v16 row_half_mirror row_mask:0xf bank_mask:0xf
    v_add_f32_dpp v17, v17, v17 row_half_mirror row_mask:0xf bank_mask:0xf
    v_add_f32_dpp v18, v18, v18 row_half_mirror row_mask:0xf bank_mask:0xf
    v_add_f32_dpp v19, v19, v19 row_half_mirror row_mask:0xf bank_mask:0xf
    v_cvt_pk_bf16_f32 v16, 0, v16
    v_cvt_pk_bf16_f32 v17, 0, v17
    v_cvt_pk_bf16_f32 v18, 0, v18
    v_cvt_pk_bf16_f32 v19, 0, v19
    v_lshlrev_b32 v20, 16, v180
    v_and_b32 v21, 0xffff0000, v180
    v_lshlrev_b32 v22, 16, v181
    v_and_b32 v23, 0xffff0000, v181
    v_add_f32 v16, v16, v20
    v_add_f32 v17, v17, v21
    v_add_f32 v18, v18, v22
    v_add_f32 v19, v19, v23
    v_cvt_pk_bf16_f32 v16, 0, v16
    v_cvt_pk_bf16_f32 v17, 0, v17
    v_cvt_pk_bf16_f32 v18, 0, v18
    v_cvt_pk_bf16_f32 v19, 0, v19
    v_max_f32 v16, 0, v16
    v_max_f32 v17, 0, v17
    v_max_f32 v18, 0, v18
    v_max_f32 v19, 0, v19
    v_mul_f32 v16, v16, v16
    v_mul_f32 v17, v17, v17
    v_mul_f32 v18, v18, v18
    v_mul_f32 v19, v19, v19
    v_cvt_pk_bf16_f32 v5, v16, v16
    v_and_b32 v184, v5, v10
    v_and_b32 v185, v5, v11
    v_and_b32 v186, v5, v12
    v_and_b32 v187, v5, v13
    v_cvt_pk_bf16_f32 v5, v17, v17
    v_and_b32 v188, v5, v10
    v_and_b32 v189, v5, v11
    v_and_b32 v190, v5, v12
    v_and_b32 v191, v5, v13
    v_cvt_pk_bf16_f32 v5, v18, v18
    v_and_b32 v192, v5, v10
    v_and_b32 v193, v5, v11
    v_and_b32 v194, v5, v12
    v_and_b32 v195, v5, v13
    v_cvt_pk_bf16_f32 v5, v19, v19
    v_and_b32 v196, v5, v10
    v_and_b32 v197, v5, v11
    v_and_b32 v198, v5, v12
    v_and_b32 v199, v5, v13
L_Cnoh2:
    s_waitcnt lgkmcnt(0)
    s_barrier
    s_cmp_eq_u32 s45, 0
    s_cbranch_scc1 L_Cnoffn2
    s_waitcnt vmcnt(4)
    v_mfma_f32_16x16x32_bf16 v[176:179], v[184:187], v[112:115], v[176:179]
    v_mfma_f32_16x16x32_bf16 v[176:179], v[188:191], v[116:119], v[176:179]
    v_mfma_f32_16x16x32_bf16 v[176:179], v[192:195], v[120:123], v[176:179]
    v_mfma_f32_16x16x32_bf16 v[176:179], v[196:199], v[124:127], v[176:179]
L_Cnoffn2:
    s_waitcnt vmcnt(2)
    global_load_dwordx4 v[152:155], v26, s[26:27] offset:0 sc1
    global_load_dwordx4 v[156:159], v26, s[26:27] offset:256 sc1
    global_load_dwordx4 v[144:147], v24, s[26:27] offset:0 sc1
    global_load_dwordx4 v[148:151], v24, s[26:27] offset:1024 sc1
    s_nop 2
    ds_write_b128 v30, v[176:179] offset:13824
    s_mov_b32 s46, 0
    s_branch L_pollO_c
L_pollO:
    global_load_dwordx4 v[152:155], v26, s[26:27] offset:0 sc1
    global_load_dwordx4 v[156:159], v26, s[26:27] offset:256 sc1
    global_load_dwordx4 v[144:147], v24, s[26:27] offset:0 sc1
    global_load_dwordx4 v[148:151], v24, s[26:27] offset:1024 sc1
L_pollO_c:
    s_waitcnt vmcnt(0)
L_pollO_f:
    v_bitop3_b32 v32, v152, v153, v154 bitop3:0x7e
    v_bitop3_b32 v33, v154, v155, s28 bitop3:0x7e
    v_bitop3_b32 v34, v156, v157, v158 bitop3:0x7e
    v_bitop3_b32 v35, v158, v159, s28 bitop3:0x7e
    v_bitop3_b32 v36, v144, v145, v146 bitop3:0x7e
    v_bitop3_b32 v37, v146, v147, s28 bitop3:0x7e
    v_bitop3_b32 v38, v148, v149, v150 bitop3:0x7e
    v_bitop3_b32 v39, v150, v151, s28 bitop3:0x7e
    v_or3_b32 v32, v32, v33, v34
    v_or3_b32 v32, v32, v35, v36
    v_or3_b32 v32, v32, v37, v38
    v_bitop3_b32 v7, v32, v39, v15 bitop3:0xa8
    v_cmp_ne_u32 vcc, 0, v7
    s_nop 0
    s_and_b64 exec, exec, vcc
    s_cbranch_scc0 L_pollO_x
    s_add_u32 s46, s46, 1
    s_cmp_gt_u32 s46, 200000
    s_cbranch_scc1 L_pollO_x
    s_cmp_eq_u32 s53, 1
    s_cbranch_scc1 L_pollO
    s_and_b32 s52, s46, 1
    s_cbranch_scc0 L_pollO
    global_load_dwordx4 v[152:155], v26, s[48:49] offset:0 sc1
    global_load_dwordx4 v[156:159], v26, s[48:49] offset:256 sc1
    global_load_dwordx4 v[144:147], v203, s[48:49] offset:0 sc1
    global_load_dwordx4 v[148:151], v204, s[48:49] offset:0 sc1
    s_branch L_pollO_c
L_pollO_x:
    s_mov_b64 exec, -1
    v_xor_b32 v152, s28, v152
    v_xor_b32 v156, s28, v156
    v_max_f32 v5, v152, v156
    v_xor_b32 v144, s28, v144
    v_xor_b32 v145, s28, v145
    v_max_f32_dpp v5, v5, v5 quad_perm:[1,0,3,2] row_mask:0xf bank_mask:0xf
    v_xor_b32 v146, s28, v146
    v_xor_b32 v147, s28, v147
    v_max_f32_dpp v5, v5, v5 quad_perm:[2,3,0,1] row_mask:0xf bank_mask:0xf
    v_xor_b32 v148, s28, v148
    v_xor_b32 v149, s28, v149
    v_max_f32_dpp v5, v5, v5 row_half_mirror row_mask:0xf bank_mask:0xf
    v_xor_b32 v150, s28, v150
    v_sub_f32 v152, v152, v5
    v_sub_f32 v156, v156, v5
    v_mul_f32 v6, 1069066811, v152
    v_mul_f32 v8, 1069066811, v156
    v_exp_f32 v6, v6
    v_exp_f32 v8, v8
    v_xor_b32 v151, s28, v151
    v_xor_b32 v153, s28, v153
    v_xor_b32 v157, s28, v157
    v_mul_f32 v153, v153, v6
    v_pk_mul_f32 v[144:145], v[144:145], v[6:7] op_sel_hi:[1,0]
    v_pk_mul_f32 v[146:147], v[146:147], v[6:7] op_sel_hi:[1,0]
    v_fmac_f32 v153, v157, v8
    v_pk_fma_f32 v[144:145], v[148:149], v[8:9], v[144:145] op_sel_hi:[1,0,1]
    v_pk_fma_f32 v[146:147], v[150:151], v[8:9], v[146:147] op_sel_hi:[1,0,1]
    v_add_f32_dpp v153, v153, v153 quad_perm:[1,0,3,2] row_mask:0xf bank_mask:0xf
    v_add_f32_dpp v144, v144, v144 quad_perm:[1,0,3,2] row_mask:0xf bank_mask:0xf
    v_add_f32_dpp v145, v145, v145 quad_perm:[1,0,3,2] row_mask:0xf bank_mask:0xf
    v_add_f32_dpp v146, v146, v146 quad_perm:[1,0,3,2] row_mask:0xf bank_mask:0xf
    v_add_f32_dpp v147, v147, v147 quad_perm:[1,0,3,2] row_mask:0xf bank_mask:0xf
    v_add_f32_dpp v153, v153, v153 quad_perm:[2,3,0,1] row_mask:0xf bank_mask:0xf
    v_add_f32_dpp v144, v144, v144 quad_perm:[2,3,0,1] row_mask:0xf bank_mask:0xf
    v_add_f32_dpp v145, v145, v145 quad_perm:[2,3,0,1] row_mask:0xf bank_mask:0xf
    v_add_f32_dpp v146, v146, v146 quad_perm:[2,3,0,1] row_mask:0xf bank_mask:0xf
    v_add_f32_dpp v147, v147, v147 quad_perm:[2,3,0,1] row_mask:0xf bank_mask:0xf
    v_add_f32_dpp v153, v153, v153 row_half_mirror row_mask:0xf bank_mask:0xf
    v_add_f32_dpp v144, v144, v144 row_half_mirror row_mask:0xf bank_mask:0xf
    v_rcp_f32 v6, v153
    v_add_f32_dpp v145, v145, v145 row_half_mirror row_mask:0xf bank_mask:0xf
    v_add_f32_dpp v146, v146, v146 row_half_mirror row_mask:0xf bank_mask:0xf
    v_add_f32_dpp v147, v147, v147 row_half_mirror row_mask:0xf bank_mask:0xf
    v_pk_mul_f32 v[144:145], v[144:145], v[6:7] op_sel_hi:[1,0]
    v_pk_mul_f32 v[146:147], v[146:147], v[6:7] op_sel_hi:[1,0]
    v_cvt_pk_bf16_f32 v5, v144, v144
    v_and_b32 v48, v5, v10
    v_and_b32 v49, v5, v11
    v_and_b32 v50, v5, v12
    v_and_b32 v51, v5, v13
    v_cvt_pk_bf16_f32 v8, v145, v145
    v_and_b32 v52, v8, v10
    v_and_b32 v53, v8, v11
    v_and_b32 v54, v8, v12
    v_and_b32 v55, v8, v13
    v_mfma_f32_16x16x32_bf16 v[32:35], v[48:51], v[128:131], 0
    v_cvt_pk_bf16_f32 v5, v146, v146
    v_and_b32 v56, v5, v10
    v_and_b32 v57, v5, v11
    v_and_b32 v58, v5, v12
    v_and_b32 v59, v5, v13
    v_mfma_f32_16x16x32_bf16 v[32:35], v[52:55], v[132:135], v[32:35]
    v_cvt_pk_bf16_f32 v8, v147, v147
    v_and_b32 v60, v8, v10
    v_and_b32 v61, v8, v11
    v_and_b32 v62, v8, v12
    v_and_b32 v63, v8, v13
    v_mfma_f32_16x16x32_bf16 v[32:35], v[56:59], v[136:139], v[32:35]
    s_nop 0
    v_mfma_f32_16x16x32_bf16 v[32:35], v[60:63], v[140:143], v[32:35]
    s_nop 7
    ds_write_b128 v30, v[32:35] offset:9728
    s_cmp_ge_u32 s29, 2
    s_cbranch_scc1 L_Cbar
    s_waitcnt lgkmcnt(0)
    s_barrier
    ds_read2st64_b64 v[148:151], v31 offset0:0 offset1:2
    ds_read2st64_b64 v[152:155], v31 offset0:4 offset1:6
    ds_read2st64_b64 v[156:159], v31 offset0:8 offset1:10
    s_waitcnt lgkmcnt(2)
    v_pk_add_f32 v[144:145], v[148:149], v[150:151]
    s_waitcnt lgkmcnt(1)
    v_pk_add_f32 v[152:153], v[152:153], v[154:155]
    v_pk_add_f32 v[144:145], v[144:145], v[152:153]
    s_waitcnt lgkmcnt(0)
    v_pk_add_f32 v[146:147], v[156:157], v[158:159]
    v_bfi_b32 v144, v15, v14, v144
    v_bfi_b32 v145, v15, v14, v145
    v_bfi_b32 v146, v15, v14, v146
    v_bfi_b32 v147, v15, v14, v147
    global_store_dwordx4 v27, v[144:147], s[26:27] sc1
    s_waitcnt vmcnt(0)
L_Cfin:
    s_mov_b32 s46, 0
    s_mov_b64 s[54:55], -1
    global_load_dwordx4 v[160:163], v28, s[26:27] offset:0 sc1
    global_load_dwordx4 v[168:171], v28, s[26:27] offset:0 sc1
L_pollS:
    s_waitcnt vmcnt(1)
    v_bitop3_b32 v32, v160, v161, v162 bitop3:0x7e
    v_bitop3_b32 v33, v162, v163, s28 bitop3:0x7e
    v_bitop3_b32 v7, v32, v33, v15 bitop3:0xa8
    v_cmp_ne_u32 vcc, 0, v7
    s_nop 0
    s_andn2_b64 exec, exec, vcc
    v_xor_b32 v144, s28, v160
    v_xor_b32 v145, s28, v161
    v_xor_b32 v146, s28, v162
    v_xor_b32 v147, s28, v163
    s_and_b64 exec, s[54:55], vcc
    s_cbranch_scc0 L_pollS_x
    s_mov_b64 s[54:55], exec
    global_load_dwordx4 v[160:163], v28, s[26:27] offset:0 sc1
    s_waitcnt vmcnt(1)
    v_bitop3_b32 v32, v168, v169, v170 bitop3:0x7e
    v_bitop3_b32 v33, v170, v171, s28 bitop3:0x7e
    v_bitop3_b32 v7, v32, v33, v15 bitop3:0xa8
    v_cmp_ne_u32 vcc, 0, v7
    s_nop 0
    s_andn2_b64 exec, exec, vcc
    v_xor_b32 v144, s28, v168
    v_xor_b32 v145, s28, v169
    v_xor_b32 v146, s28, v170
    v_xor_b32 v147, s28, v171
    s_and_b64 exec, s[54:55], vcc
    s_cbranch_scc0 L_pollS_x
    s_mov_b64 s[54:55], exec
    global_load_dwordx4 v[168:171], v28, s[26:27] offset:0 sc1
    s_add_u32 s46, s46, 1
    s_cmp_lt_u32 s46, 200000
    s_cbranch_scc1 L_pollS
L_pollS_x:
    s_mov_b64 exec, -1
    v_permlane32_swap_b32 v146, v147
    v_permlane32_swap_b32 v144, v145
    v_add_f32 v146, v146, v147
    v_add_f32 v144, v144, v145
    v_mov_b32 v147, v146
    v_mov_b32 v145, v144
    s_nop 0
    v_permlane16_swap_b32 v146, v147
    v_permlane16_swap_b32 v144, v145
    v_add_f32 v146, v146, v147
    v_add_f32 v144, v144, v145
    s_nop 0
    v_add_f32_dpp v146, v146, v146 quad_perm:[1,0,3,2] row_mask:0xf bank_mask:0xf
    v_add_f32_dpp v144, v144, v144 quad_perm:[1,0,3,2] row_mask:0xf bank_mask:0xf
    s_nop 0
    v_add_f32_dpp v146, v146, v146 quad_perm:[2,3,0,1] row_mask:0xf bank_mask:0xf
    v_add_f32_dpp v144, v144, v144 quad_perm:[2,3,0,1] row_mask:0xf bank_mask:0xf
    s_nop 0
    v_add_f32_dpp v146, v146, v146 row_half_mirror row_mask:0xf bank_mask:0xf
    v_add_f32_dpp v144, v144, v144 row_half_mirror row_mask:0xf bank_mask:0xf
    s_nop 0
    v_add_f32_dpp v146, v146, v146 row_mirror row_mask:0xf bank_mask:0xf
    v_cvt_pk_bf16_f32 v6, 0, v146
    v_add_f32 v6, v6, v201
    v_cvt_pk_bf16_f32 v6, 0, v6
    v_mul_f32 v7, 3216550459, v6
    v_exp_f32 v7, v7
    v_add_f32_dpp v144, v144, v144 row_mirror row_mask:0xf bank_mask:0xf
    v_add_f32 v7, 1.0, v7
    v_rcp_f32 v7, v7
    v_cvt_pk_bf16_f32 v5, 0, v144
    v_mul_f32 v6, v6, v7
    v_cvt_pk_bf16_f32 v6, 0, v6
    v_mul_f32 v5, v5, v6
    v_cvt_pk_bf16_f32 v5, 0, v5
    v_add_f32 v5, v5, v200
    v_cvt_pk_bf16_f32 v5, v5, v5
    s_mov_b32 exec_lo, 1
    s_mov_b32 exec_hi, 1
    global_store_short v202, v5, s[24:25]
    s_or_b32 s40, s2, s29
    s_cbranch_scc1 L_Cdone
    s_mov_b64 exec, 1
    v_mov_b32 v5, 0
    global_store_dword v5, v14, s[26:27]
L_Cdone:
    s_endpgm
L_Cbar:
    s_waitcnt lgkmcnt(0)
    s_barrier
    s_endpgm
.fill 416, 4, 0xbf810000
.section .rodata,"a"
.p2align 6
.amdhsa_kernel recurrent_scan__sliding_block_cached__dense_activation_squared_relu__decode_kernel
  .amdhsa_next_free_vgpr 216
  .amdhsa_next_free_sgpr 102
  .amdhsa_accum_offset 216
  .amdhsa_group_segment_fixed_size 0
  .amdhsa_kernarg_size 104
  .amdhsa_user_sgpr_count 2
  .amdhsa_user_sgpr_kernarg_segment_ptr 1
  .amdhsa_system_sgpr_workgroup_id_x 1
  .amdhsa_float_denorm_mode_32 3
.end_amdhsa_kernel
```
